```python
import torch

def _softmax(x, axis=-1):
    return torch.softmax(x, dim=axis)
def _gelu(x):
    return torch.nn.functional.gelu(x, approximate="tanh")
def _silu(x):
    return torch.nn.functional.silu(x)
def _sigmoid(x):
    return torch.sigmoid(x)
def _layernorm(x, axis=-1, eps=1e-5):
    m = x.mean(dim=axis, keepdim=True)
    v = x.var(dim=axis, keepdim=True, unbiased=False)
    return (x - m) / torch.sqrt(v + eps)
def _scatter_add(tgt, idx, src, axis=0):
    return tgt.clone().index_add_(axis, idx, src)
def _segment_sum(src, seg, n):
    out = torch.zeros((n,) + src.shape[1:], dtype=src.dtype)
    return out.index_add_(0, seg, src)
def _pad(x, pw):
    flat = tuple(v for pair in reversed(pw) for v in pair)
    return torch.nn.functional.pad(x, flat)

kernel_name = 'gated_mix__compressed_kv_cla__dense_activation_silu__decode'

def setup_inputs():

    _w = (lambda a: (lambda t: t.to(torch.bfloat16) if t.is_floating_point() else t)(torch.as_tensor(a)))
    def _A_setup():
        B, H, Sq, Sk, D, M = 1, 32, 1, 4096, 128, 640
        Dc = 4 * D
        return {
            "x": _w((lambda *s: torch.randn(*s, dtype=torch.bfloat16) * 0.05)(B, Sq, M)),
            "c_kv": _w((lambda *s: torch.randn(*s, dtype=torch.bfloat16) * 0.2)(B, Sk, Dc)),
            "w_q": _w((lambda *s: torch.randn(*s, dtype=torch.bfloat16) * 3.2)(M, H, D) * (M ** -0.5)),
            "w_uk": _w((lambda *s: torch.randn(*s, dtype=torch.bfloat16) * 3.2)(Dc, H, D) * (Dc ** -0.5)),
            "w_uv": _w((lambda *s: torch.randn(*s, dtype=torch.bfloat16) * 0.2)(Dc, H, D) * (Dc ** -0.5)),
            "w_o": _w((lambda *s: torch.randn(*s, dtype=torch.bfloat16) * 0.2)(H, D, M) * ((H * D) ** -0.5)),
        }
    _A_in = _A_setup()

    def _B_setup():
        B, S, D, F = 1, 1, 640, 1728
        return {
            "x": _w((lambda *s: torch.randn(*s, dtype=torch.bfloat16) * 0.05)(B, S, D)),
            "w1": _w((lambda *s: torch.randn(*s, dtype=torch.bfloat16) * 0.05)(D, F) * (D ** -0.5)),
            "w2": _w((lambda *s: torch.randn(*s, dtype=torch.bfloat16) * 0.05)(F, D) * (F ** -0.5)),
        }
    _B_in = _B_setup()

    return {
        "A_x": _A_in["x"],
        "A_c_kv": _A_in["c_kv"],
        "A_w_q": _A_in["w_q"],
        "A_w_uk": _A_in["w_uk"],
        "A_w_uv": _A_in["w_uv"],
        "A_w_o": _A_in["w_o"],
        "B_x": _B_in["x"],
        "B_w1": _B_in["w1"],
        "B_w2": _B_in["w2"],
        "gate_w": _w((lambda *s: torch.randn(*s, dtype=torch.bfloat16) * 0.05)(640) * 16.0),
    }

def reference(A_x, A_c_kv, A_w_q, A_w_uk, A_w_uv, A_w_o, B_x, B_w1, B_w2, gate_w):
    def _A_ref(x, c_kv, w_q, w_uk, w_uv, w_o):
        B, Sq, M = x.shape[0], x.shape[1], x.shape[2]
        Sk = c_kv.shape[1]
        H, D = w_q.shape[1], w_q.shape[2]
        q = torch.einsum("bqm,mhd->bhqd", x, w_q)
        k = torch.einsum("bkc,chd->bhkd", c_kv, w_uk)
        v = torch.einsum("bkc,chd->bhkd", c_kv, w_uv)
        scores = torch.einsum("bhqd,bhkd->bhqk", q, k) * (D ** -0.5)
        off = Sk - Sq
        qi = torch.arange(Sq)[:, None]
        kj = torch.arange(Sk)[None, :]
        cmask = kj <= (qi + off)
        scores = torch.where(cmask[None, None], scores, -1e9)
        p = _softmax(scores, axis=-1)
        ctx = torch.einsum("bhqk,bhkd->bhqd", p, v)
        return torch.einsum("bhqd,hdm->bqm", ctx, w_o)

    def _B_ref(x, w1, w2):
        h = torch.einsum("bsd,df->bsf", x, w1)
        h = _silu(h)
        out = torch.einsum("bsf,fd->bsd", h, w2)
        return out

    x = A_x
    g = _sigmoid((x * gate_w).sum(-1, keepdims=True))
    a = _A_ref(x, A_c_kv, A_w_q, A_w_uk, A_w_uv, A_w_o)
    b = _B_ref(x, B_w1, B_w2)
    return g * a + (1 - g) * b
```

```asm
; @launch grid=(256,1,1) block=(512,1,1) lds=163840
.amdgcn_target "amdgcn-amd-amdhsa--gfx950"
.text
.globl gated_mix__compressed_kv_cla__dense_activation_silu__decode_kernel
.p2align 8
.type gated_mix__compressed_kv_cla__dense_activation_silu__decode_kernel,@function
gated_mix__compressed_kv_cla__dense_activation_silu__decode_kernel:
    s_load_dwordx2 s[52:53], s[0:1], 16
    s_load_dwordx16 s[16:31], s[0:1], 0
    s_load_dwordx2 s[44:45], s[0:1], 96
    s_getpc_b64 s[8:9]
    v_readfirstlane_b32 s3, v0
    s_lshr_b32 s7, s2, 7
    s_cmp_gt_u32 s7, 1
    s_cbranch_scc1 L_exit
    s_lshr_b32 s10, s2, 3
    s_and_b32 s5, s10, 3
    s_lshl_b32 s10, s10, 9
    v_and_b32 v3, 3, v0
    v_lshl_add_u32 v3, v3, 7, s10
    global_load_dword v255, v3, s[8:9]
    s_andn2_b32 s4, 7, s2
    s_bfe_u32 s6, s2, 0x20005
    s_lshl2_add_u32 s6, s4, s6
    v_and_b32 v1, 15, v0
    v_bfe_u32 v2, v0, 4, 2
    v_lshlrev_b32 v5, 4, v1
    s_lshl_b32 s9, s6, 8
    s_lshr_b32 s3, s3, 6
    s_cmp_ge_u32 s3, 2
    s_cbranch_scc1 L_other
    s_lshl1_add_u32 s10, s7, s3
    s_lshl2_add_u32 s10, s5, s10
    s_mul_i32 s8, s10, 327680
    s_add_u32 s8, s8, s9
    v_mul_u32_u24 v4, 81920, v2
    v_add_u32 v4, v4, v5
    s_mov_b32 s54, 5242880
    s_mov_b32 s55, 0x20000
    s_waitcnt lgkmcnt(0)
    buffer_load_dwordx4 v[64:67], v4, s[52:55], s8 offen nt
    s_addk_i32 s8, 0x2000
    buffer_load_dwordx4 v[68:71], v4, s[52:55], s8 offen nt
    s_addk_i32 s8, 0x2000
    buffer_load_dwordx4 v[72:75], v4, s[52:55], s8 offen nt
    s_addk_i32 s8, 0x2000
    buffer_load_dwordx4 v[76:79], v4, s[52:55], s8 offen nt
    s_addk_i32 s8, 0x2000
    buffer_load_dwordx4 v[80:83], v4, s[52:55], s8 offen nt
    s_addk_i32 s8, 0x2000
    buffer_load_dwordx4 v[84:87], v4, s[52:55], s8 offen nt
    s_addk_i32 s8, 0x2000
    s_branch L_s1
.p2align 8
L_other:
    v_and_b32 v0, 63, v0
    v_lshlrev_b32 v3, 4, v0
    s_cmp_eq_u32 s7, 0
    s_cbranch_scc1 L_F
    s_cmp_ge_u32 s3, 4
    s_cbranch_scc1 L_B_q0
    s_barrier
    s_branch L_B_pv
L_B_q0:
    s_sub_u32 s15, s3, 4
    s_and_b32 s62, s5, 1
    s_lshl_b32 s62, s62, 4
    s_lshl2_add_u32 s63, s6, s15
    s_lshl_b32 s63, s63, 15
    s_mul_i32 s61, s15, 33792
    s_add_u32 s60, s61, 6336
    s_waitcnt lgkmcnt(0)
    s_mov_b64 s[48:49], s[18:19]
    s_mov_b32 s50, 4194304
    s_mov_b32 s51, 0x20000
    s_barrier
L_B_dma:
    s_mov_b32 m0, s61
    s_lshl_b32 s9, s62, 10
    s_add_u32 s9, s9, s63
    buffer_load_dwordx4 v3, s[48:51], s9 offen lds
    s_add_u32 s62, s62, 1
    s_and_b32 s62, s62, 31
    s_addk_i32 s61, 1056
    s_cmp_lt_u32 s61, s60
    s_cbranch_scc1 L_B_dma
    s_branch L_B_qk
L_F:
    s_waitcnt lgkmcnt(0)
    s_load_dword s42, s[44:45], 0
    s_load_dwordx8 s[32:39], s[0:1], 64
    s_mov_b32 s46, 16777216
    s_mov_b32 s47, 0x20000
    s_lshl2_add_u32 s12, s6, s5
    s_cmp_lg_u32 s3, 6
    s_cbranch_scc1 L_1
    s_lshl_b32 s13, s12, 11
    s_addk_i32 s13, 4096
    buffer_load_dwordx4 v[8:11], v3, s[44:47], s13 offen sc1
    buffer_load_dwordx4 v[8:11], v3, s[44:47], s13 offen offset:1024 sc1
L_1:
    s_cmp_lg_u32 s3, 7
    s_cbranch_scc1 L_2
    v_mov_b32 v12, -1
    v_lshlrev_b32 v13, 2, v0
    s_lshl_b32 s13, s12, 8
    s_add_u32 s13, s13, 266240
    buffer_store_dword v12, v13, s[44:47], s13 offen sc1
L_2:
    s_barrier
    s_mov_b64 s[56:57], s[22:23]
    s_mov_b32 s58, 4194304
    s_mov_b32 s59, 0x20000
    v_lshl_add_u32 v6, v2, 13, v5
    s_mul_i32 m0, s3, 4160
    s_lshl3_add_u32 s15, s5, s3
    s_lshl_b32 s15, s15, 17
    s_add_u32 s15, s15, s9
    buffer_load_dwordx4 v6, s[56:59], s15 offen nt lds
    s_add_u32 s15, s15, 0x8000
    s_add_u32 m0, m0, 1040
    s_nop 0
    buffer_load_dwordx4 v6, s[56:59], s15 offen nt lds
    s_add_u32 s15, s15, 0x8000
    s_add_u32 m0, m0, 1040
    s_nop 0
    buffer_load_dwordx4 v6, s[56:59], s15 offen nt lds
    s_add_u32 s15, s15, 0x8000
    s_add_u32 m0, m0, 1040
    s_nop 0
    buffer_load_dwordx4 v6, s[56:59], s15 offen nt lds
    s_branch L_F_w
L_s1:
    s_cmp_eq_u32 s7, 0
    s_cbranch_scc1 L_s1_nm
    s_mov_b32 s46, 16777216
    s_mov_b32 s47, 0x20000
    s_lshl2_add_u32 s12, s6, s5
    v_lshlrev_b32 v3, 4, v0
    s_sub_u32 s11, s3, 1
    v_mov_b32 v16, s11
    v_mov_b32 v17, s11
    v_mov_b32 v18, s11
    v_mov_b32 v19, s11
    s_cbranch_scc0 L_s1_m1
    s_lshl_b32 s13, s12, 8
    s_add_u32 s13, s13, 266240
    s_mov_b64 exec, 0xffff
    s_branch L_s1_m2
L_s1_m1:
    s_mul_i32 s13, s12, 640
    s_add_u32 s13, s13, 510976
    s_mov_b32 exec_hi, 0xff
    buffer_store_dwordx4 v[16:19], v3, s[44:47], s13 offen
L_s1_m2:
    s_mov_b64 exec, -1
L_s1_nm:
    s_mov_b64 s[48:49], s[16:17]
    s_mov_b32 s50, 1280
    s_mov_b32 s51, 0x20000
    v_mul_u32_u24 v3, 20, v2
    s_mul_i32 s11, s10, 80
    buffer_load_dwordx4 v[8:11], v3, s[48:51], s11 offen
    buffer_load_dword v12, v3, s[48:51], s11 offen offset:16
    buffer_load_dwordx4 v[88:91], v4, s[52:55], s8 offen nt
    s_addk_i32 s8, 0x2000
    buffer_load_dwordx4 v[92:95], v4, s[52:55], s8 offen nt
    s_addk_i32 s8, 0x2000
    buffer_load_dwordx4 v[96:99], v4, s[52:55], s8 offen nt
    s_addk_i32 s8, 0x2000
    buffer_load_dwordx4 v[100:103], v4, s[52:55], s8 offen nt
    v_and_b32 v0, 63, v0
    v_lshlrev_b32 v3, 4, v0
    s_load_dword s42, s[44:45], 0
    s_load_dwordx8 s[32:39], s[0:1], 64
    s_mov_b32 s46, 16777216
    s_mov_b32 s47, 0x20000
    s_cmp_eq_u32 s7, 0
    s_cbranch_scc1 L_s1_f
    s_barrier
    s_waitcnt lgkmcnt(0)
    v_lshlrev_b32 v4, 2, v0
    s_mov_b64 s[52:53], s[34:35]
    s_mov_b32 s54, 1280
    s_mov_b32 s55, 0x20000
    buffer_load_dwordx4 v[48:51], v3, s[48:51], 0 offen
    buffer_load_dword v52, v4, s[48:51], 0 offen offset:1024
    buffer_load_dwordx4 v[56:59], v3, s[52:55], 0 offen
    buffer_load_dword v60, v4, s[52:55], 0 offen offset:1024
    s_branch L_s1_j
L_s1_f:
    s_mov_b64 s[56:57], s[22:23]
    s_mov_b32 s58, 4194304
    s_mov_b32 s59, 0x20000
    v_lshl_add_u32 v6, v2, 13, v5
    s_mul_i32 m0, s3, 4160
    s_lshl3_add_u32 s15, s5, s3
    s_lshl_b32 s15, s15, 17
    s_add_u32 s15, s15, s9
    buffer_load_dwordx4 v6, s[56:59], s15 offen nt lds
    s_add_u32 s15, s15, 0x8000
    s_add_u32 m0, m0, 1040
    s_nop 0
    buffer_load_dwordx4 v6, s[56:59], s15 offen nt lds
    s_add_u32 s15, s15, 0x8000
    s_add_u32 m0, m0, 1040
    s_nop 0
    buffer_load_dwordx4 v6, s[56:59], s15 offen nt lds
    s_add_u32 s15, s15, 0x8000
    s_add_u32 m0, m0, 1040
    s_nop 0
    buffer_load_dwordx4 v6, s[56:59], s15 offen nt lds
    s_barrier
L_s1_j:
    v_mov_b32 v32, 0x0100
    v_mov_b32 v33, 0x0302
    v_cmp_gt_u32 vcc, 8, v1
    v_and_b32 v34, 1, v1
    s_nop 0
    v_cndmask_b32 v32, v33, v32, vcc
    v_cmp_eq_u32 vcc, 0, v34
    v_or_b32 v33, 0x0c0c0000, v32
    v_lshlrev_b32 v32, 16, v32
    v_or_b32 v32, 0x0c0c, v32
    v_cndmask_b32 v32, v32, v33, vcc
    v_bfe_u32 v34, v1, 1, 2
    v_mov_b32 v33, 0x0c0c0c0c
    v_cmp_eq_u32 vcc, 0, v34
    s_nop 1
    v_cndmask_b32 v28, v33, v32, vcc
    v_cmp_eq_u32 vcc, 1, v34
    s_nop 1
    v_cndmask_b32 v29, v33, v32, vcc
    v_cmp_eq_u32 vcc, 2, v34
    s_nop 1
    v_cndmask_b32 v30, v33, v32, vcc
    v_cmp_eq_u32 vcc, 3, v34
    s_nop 1
    v_cndmask_b32 v31, v33, v32, vcc
    s_lshl4_add_u32 s13, s6, s10
    s_lshl_b32 s13, s13, 9
    s_add_u32 s13, s13, 4096
    s_add_u32 s14, s13, 4194304
    s_mov_b32 s68, 1040356334
    s_waitcnt lgkmcnt(0)
    s_add_u32 s43, s42, 0x9E3779B1
    s_getreg_b32 s11, hwreg(HW_REG_XCC_ID)
    v_mov_b32 v38, s11
    v_mov_b32 v39, s43
    s_waitcnt vmcnt(8)
    v_perm_b32 v32, v8, v8, v28
    v_perm_b32 v33, v8, v8, v29
    v_perm_b32 v34, v8, v8, v30
    v_perm_b32 v35, v8, v8, v31
    s_nop 1
    v_mfma_f32_16x16x32_bf16 v[40:43], v[32:35], v[64:67], 0
    v_mfma_f32_16x16x32_bf16 v[44:47], v[32:35], v[68:71], 0
    v_perm_b32 v32, v9, v9, v28
    v_perm_b32 v33, v9, v9, v29
    v_perm_b32 v34, v9, v9, v30
    v_perm_b32 v35, v9, v9, v31
    s_nop 1
    v_mfma_f32_16x16x32_bf16 v[40:43], v[32:35], v[72:75], v[40:43]
    v_mfma_f32_16x16x32_bf16 v[44:47], v[32:35], v[76:79], v[44:47]
    v_perm_b32 v32, v10, v10, v28
    v_perm_b32 v33, v10, v10, v29
    v_perm_b32 v34, v10, v10, v30
    v_perm_b32 v35, v10, v10, v31
    s_nop 1
    v_mfma_f32_16x16x32_bf16 v[40:43], v[32:35], v[80:83], v[40:43]
    v_mfma_f32_16x16x32_bf16 v[44:47], v[32:35], v[84:87], v[44:47]
    v_perm_b32 v32, v11, v11, v28
    v_perm_b32 v33, v11, v11, v29
    v_perm_b32 v34, v11, v11, v30
    v_perm_b32 v35, v11, v11, v31
    s_waitcnt vmcnt(7)
    s_nop 0
    v_mfma_f32_16x16x32_bf16 v[40:43], v[32:35], v[88:91], v[40:43]
    s_waitcnt vmcnt(6)
    v_mfma_f32_16x16x32_bf16 v[44:47], v[32:35], v[92:95], v[44:47]
    v_perm_b32 v32, v12, v12, v28
    v_perm_b32 v33, v12, v12, v29
    v_perm_b32 v34, v12, v12, v30
    v_perm_b32 v35, v12, v12, v31
    s_waitcnt vmcnt(5)
    s_nop 0
    v_mfma_f32_16x16x32_bf16 v[40:43], v[32:35], v[96:99], v[40:43]
    s_waitcnt vmcnt(4)
    v_mfma_f32_16x16x32_bf16 v[44:47], v[32:35], v[100:103], v[44:47]
    s_nop 5
    v_mul_f32 v40, s68, v40
    v_mul_f32 v41, s68, v41
    v_mul_f32 v42, s68, v42
    v_mul_f32 v43, s68, v43
    v_permlane32_swap_b32 v44, v32
    v_permlane32_swap_b32 v45, v33
    v_permlane32_swap_b32 v46, v34
    v_permlane32_swap_b32 v47, v35
    v_fmac_f32 v40, s68, v32
    v_fmac_f32 v41, s68, v33
    v_fmac_f32 v42, s68, v34
    v_fmac_f32 v43, s68, v35
    v_cvt_pk_bf16_f32 v36, v40, v41
    v_cvt_pk_bf16_f32 v37, v42, v43
    s_mov_b32 exec_hi, 0
    buffer_store_dwordx4 v[36:39], v3, s[44:47], s13 offen
    s_cmp_lg_u32 s7, 0
    s_cbranch_scc1 L_B_pv2
    v_lshl_add_u32 v4, s3, 9, v3
    ds_write_b128 v4, v[36:39] offset:44032
    s_mov_b64 exec, -1
L_F_w:
    s_waitcnt lgkmcnt(0)
    s_add_u32 s43, s42, 0x9E3779B1
    s_lshl2_add_u32 s12, s6, s5
    s_lshl3_add_u32 s13, s6, s3
    s_lshl_b32 s13, s13, 10
    s_add_u32 s13, s13, 4096
    s_lshl_b32 s15, s12, 8
    s_add_u32 s15, s15, 266240
    v_lshrrev_b32 v6, 2, v1
    v_mul_u32_u24 v6, 1040, v6
    v_and_b32 v7, 3, v1
    v_lshl_add_u32 v6, v7, 8, v6
    v_lshl_add_u32 v6, v2, 4, v6
    s_mul_i32 s7, s3, 4160
    v_add_u32 v6, s7, v6
    v_lshrrev_b32 v22, 5, v0
    v_lshl_add_u32 v22, s3, 1, v22
    v_mul_u32_u24 v7, 288, v22
    v_add_u32 v7, v7, v5
    v_and_b32 v4, 1, v2
    v_lshl_add_u32 v7, v4, 3, v7
    v_lshlrev_b32 v22, 2, v22
    v_mul_u32_u24 v4, 288, v1
    v_lshl_add_u32 v4, v2, 4, v4
    v_and_b32 v25, 12, v1
    v_and_b32 v24, 1, v1
    v_lshl_add_u32 v25, v24, 1, v25
    v_and_b32 v24, 2, v1
    v_lshl_add_u32 v25, v24, 3, v25
    v_lshl_add_u32 v25, s3, 5, v25
    s_mov_b64 s[48:49], s[24:25]
    s_mov_b32 s50, 4194304
    s_mov_b32 s51, 0x20000
    v_lshl_add_u32 v26, v2, 17, v5
    s_lshl_b32 s10, s5, 6
    s_add_u32 s10, s10, s3
    s_lshl_b32 s10, s10, 14
    s_add_u32 s10, s10, s9
    s_mul_i32 s11, s3, 4224
    s_add_u32 m0, s11, 45056
    s_cmp_lg_u32 s3, 7
    s_cbranch_scc1 L_3
    v_mov_b32 v23, s43
    s_lshl_b32 s7, s12, 7
    s_add_u32 s7, s7, 299008
    s_waitcnt vmcnt(4)
    s_mov_b64 exec, 1
    buffer_store_dword v23, v0, s[44:47], s7 offen sc1
    s_mov_b64 exec, -1
L_3:
    s_mov_b64 s[56:57], s[16:17]
    s_mov_b32 s58, 1280
    s_mov_b32 s59, 0x20000
    s_mov_b64 s[52:53], s[30:31]
    s_mov_b32 s54, 2211840
    s_mov_b32 s55, 0x20000
    v_mul_u32_u24 v27, 80, v2
    s_mul_i32 s7, s5, 320
    s_cmp_lg_u32 s3, 7
    s_cbranch_scc1 L_4
    buffer_load_dwordx4 v[180:183], v27, s[56:59], s7 offen offset:0
    buffer_load_dwordx4 v[184:187], v27, s[56:59], s7 offen offset:16
    buffer_load_dwordx4 v[188:191], v27, s[56:59], s7 offen offset:32
    buffer_load_dwordx4 v[192:195], v27, s[56:59], s7 offen offset:48
    buffer_load_dwordx4 v[196:199], v27, s[56:59], s7 offen offset:64
    v_mov_b32 v56, 0x0100
    v_mov_b32 v57, 0x0302
    v_cmp_gt_u32 vcc, 8, v1
    v_and_b32 v58, 1, v1
    s_nop 0
    v_cndmask_b32 v56, v57, v56, vcc
    v_cmp_eq_u32 vcc, 0, v58
    v_or_b32 v57, 0x0c0c0000, v56
    v_lshlrev_b32 v56, 16, v56
    v_or_b32 v56, 0x0c0c, v56
    v_cndmask_b32 v56, v56, v57, vcc
    v_bfe_u32 v58, v1, 1, 2
    v_mov_b32 v57, 0x0c0c0c0c
    v_cmp_eq_u32 vcc, 0, v58
    s_nop 1
    v_cndmask_b32 v52, v57, v56, vcc
    v_cmp_eq_u32 vcc, 1, v58
    s_nop 1
    v_cndmask_b32 v53, v57, v56, vcc
    v_cmp_eq_u32 vcc, 2, v58
    s_nop 1
    v_cndmask_b32 v54, v57, v56, vcc
    v_cmp_eq_u32 vcc, 3, v58
    s_nop 1
    v_cndmask_b32 v55, v57, v56, vcc
L_4:
    v_mul_u32_u24 v27, 40, v2
    v_lshrrev_b32 v28, 3, v1
    v_add_u32 v27, v27, v28
    v_mul_u32_u24 v27, 3456, v27
    v_and_b32 v28, 7, v1
    v_lshl_add_u32 v27, v28, 4, v27
    s_mul_i32 s76, s5, 552960
    s_lshl_b32 s7, s6, 7
    s_add_u32 s76, s76, s7
    s_lshl_b32 s14, s12, 11
    s_add_u32 s14, s14, 4198400
    s_waitcnt vmcnt(1)
    s_cmp_lt_u32 s3, 2
    s_cbranch_scc1 L_F_p0
    s_waitcnt vmcnt(0)
L_F_p0:
    buffer_load_dwordx4 v[8:11], v3, s[44:47], s13 offen sc1
    ds_read_b128 v[64:67], v6 offset:0
    ds_read_b128 v[68:71], v6 offset:64
    ds_read_b128 v[72:75], v6 offset:128
    ds_read_b128 v[76:79], v6 offset:192
    s_mov_b32 s66, 0
    s_branch L_wait_6
L_retry_5:
    buffer_load_dwordx4 v[8:11], v3, s[44:47], s13 offen sc1
    s_add_u32 s66, s66, 1
    s_cmp_ge_u32 s66, 48
    s_cselect_b32 s67, 4194304, 0
    s_xor_b32 s13, s13, s67
    s_cmp_ge_u32 s66, 131072
    s_cbranch_scc1 L_end
    s_cmp_eq_u32 s67, 0
    s_cbranch_scc1 L_wait_6
    ds_read_b128 v[12:15], v3 offset:44032
    s_waitcnt lgkmcnt(0)
    buffer_store_dwordx4 v[12:15], v3, s[44:47], s14 offen sc1
L_wait_6:
    s_waitcnt vmcnt(0)
L_chk_7:
    ds_write_b64 v7, v[8:9] offset:33280
    ds_write_b32 v22, v10 offset:38144
    v_cmp_ne_u32 vcc, s43, v11
    s_cbranch_vccnz L_retry_5
    s_waitcnt lgkmcnt(0)
    s_barrier
    ds_read_b128 v[80:83], v4 offset:33280
    ds_read_b128 v[84:87], v4 offset:33344
    ds_read_b128 v[88:91], v4 offset:33408
    ds_read_b128 v[92:95], v4 offset:33472
    s_waitcnt lgkmcnt(3)
    v_mfma_f32_16x16x32_bf16 v[16:19], v[80:83], v[64:67], 0
    s_waitcnt lgkmcnt(2)
    v_mfma_f32_16x16x32_bf16 v[16:19], v[84:87], v[68:71], v[16:19]
    s_waitcnt lgkmcnt(1)
    v_mfma_f32_16x16x32_bf16 v[16:19], v[88:91], v[72:75], v[16:19]
    s_waitcnt lgkmcnt(0)
    v_mfma_f32_16x16x32_bf16 v[16:19], v[92:95], v[76:79], v[16:19]
    s_nop 7
    v_pk_add_f32 v[16:17], v[16:17], v[18:19]
    v_add_f32 v16, v16, v17
    s_nop 1
    v_permlane32_swap_b32 v16, v17
    v_add_f32 v16, v16, v17
    s_nop 1
    v_permlane16_swap_b32 v16, v17
    v_add_f32 v16, v16, v17
    v_cvt_pk_bf16_f32 v20, v16, v16
    s_mov_b64 exec, 0xffff
    ds_write_b16 v25, v20 offset:37888
    s_waitcnt lgkmcnt(0)
    s_barrier
    s_cmp_eq_u32 s3, 0
    s_cbranch_scc1 L_F_pub
    s_mov_b64 exec, -1
    buffer_load_dwordx4 v26, s[48:51], s10 offen nt lds
    s_add_u32 s10, s10, 524288
    s_add_u32 m0, m0, 1056
    s_nop 0
    buffer_load_dwordx4 v26, s[48:51], s10 offen nt lds
    s_sub_u32 s10, s10, 516096
    s_add_u32 m0, m0, 1056
    s_nop 0
L_F_pub:
    s_cmp_lg_u32 s3, 0
    s_cbranch_scc1 L_8
    s_setprio 3
    ds_read_b128 v[16:19], v3 offset:37888
    s_waitcnt lgkmcnt(0)
    buffer_store_dwordx4 v[16:19], v3, s[44:47], s15 offen sc1
L_8:
    s_mov_b64 exec, -1
    s_barrier
    s_cmp_lg_u32 s3, 0
    s_cbranch_scc1 L_9
    buffer_load_dwordx4 v26, s[48:51], s10 offen nt lds
    s_add_u32 s10, s10, 524288
    s_add_u32 m0, m0, 1056
    s_nop 0
    buffer_load_dwordx4 v26, s[48:51], s10 offen nt lds
    s_sub_u32 s10, s10, 516096
    s_add_u32 m0, m0, 1056
    s_nop 0
L_9:
    s_cmp_lg_u32 s3, 7
    s_cbranch_scc1 L_10
    buffer_load_dwordx4 v26, s[48:51], s10 offen nt lds
    s_add_u32 s10, s10, 524288
    s_add_u32 m0, m0, 1056
    s_nop 0
    buffer_load_dwordx4 v26, s[48:51], s10 offen nt lds
L_10:
    s_lshr_b32 s15, s3, 1
    s_lshl2_add_u32 s15, s6, s15
    s_mul_i32 s15, s15, 640
    s_and_b32 s7, s3, 1
    s_lshl_b32 s7, s7, 8
    s_add_u32 s15, s15, s7
    s_lshl2_add_u32 s15, s5, s15
    s_add_u32 s15, s15, 512000
    s_mul_i32 s73, s12, 640
    s_add_u32 s73, s73, 512512
    v_and_b32 v12, 3, v0
    v_lshlrev_b32 v31, 5, v12
    v_mov_b32 v12, 0
    v_and_b32 v13, 4, v0
    v_lshl_add_u32 v31, v13, 2, v31
    v_and_b32 v13, 8, v0
    v_lshl_add_u32 v31, v13, 4, v31
    s_add_u32 s74, s15, 4194304
    s_add_u32 s75, s73, 4194304
    v_lshlrev_b32 v19, 2, v0
    s_mov_b64 exec, 0xffff
    ds_read_b32 v13, v19 offset:38144
    s_getreg_b32 s11, hwreg(HW_REG_XCC_ID)
    s_waitcnt lgkmcnt(0)
    v_cmp_ne_u32 vcc, s11, v13
    s_mov_b32 s78, vcc_lo
    s_cmp_eq_u32 s78, 0
    s_cbranch_scc1 L_T_np
    buffer_store_dword v12, v31, s[44:47], s74 offen sc1
    s_cmp_lg_u32 s3, 6
    s_cbranch_scc1 L_T_np
    buffer_store_dword v12, v19, s[44:47], s75 offen sc1
    s_mov_b64 exec, -1
    ds_read_b128 v[12:15], v3 offset:44032
    s_waitcnt lgkmcnt(0)
    buffer_store_dwordx4 v[12:15], v3, s[44:47], s14 offen sc1
L_T_np:
    s_mov_b64 exec, -1
    s_mov_b32 s79, 0
    s_cmp_eq_u32 s3, 7
    s_cbranch_scc1 L_T_w7
    s_barrier
    buffer_load_dwordx4 v26, s[48:51], s10 offen nt lds
    s_add_u32 s10, s10, 524288
    s_add_u32 m0, m0, 1056
    s_nop 0
    buffer_load_dwordx4 v26, s[48:51], s10 offen nt lds
    s_branch L_T_n1done
L_T_w7:
    s_cmp_lt_u32 s6, 27
    s_cbranch_scc1 L_T_w7b
    s_barrier
    s_branch L_T_n1done
L_T_w7b:
    buffer_load_dwordx4 v[100:103], v27, s[52:55], s76 offen nt
    s_addk_i32 s76, 6912
    buffer_load_dwordx4 v[104:107], v27, s[52:55], s76 offen nt
    s_addk_i32 s76, 6912
    buffer_load_dwordx4 v[108:111], v27, s[52:55], s76 offen nt
    s_addk_i32 s76, 6912
    buffer_load_dwordx4 v[112:115], v27, s[52:55], s76 offen nt
    s_addk_i32 s76, 6912
    buffer_load_dwordx4 v[116:119], v27, s[52:55], s76 offen nt
    s_addk_i32 s76, 6912
    buffer_load_dwordx4 v[120:123], v27, s[52:55], s76 offen nt
    s_addk_i32 s76, 6912
    buffer_load_dwordx4 v[124:127], v27, s[52:55], s76 offen nt
    s_addk_i32 s76, 6912
    buffer_load_dwordx4 v[128:131], v27, s[52:55], s76 offen nt
    s_addk_i32 s76, 6912
    buffer_load_dwordx4 v[132:135], v27, s[52:55], s76 offen nt
    s_addk_i32 s76, 6912
    buffer_load_dwordx4 v[136:139], v27, s[52:55], s76 offen nt
    s_addk_i32 s76, 6912
    buffer_load_dwordx4 v[140:143], v27, s[52:55], s76 offen nt
    s_addk_i32 s76, 6912
    buffer_load_dwordx4 v[144:147], v27, s[52:55], s76 offen nt
    s_addk_i32 s76, 6912
    buffer_load_dwordx4 v[148:151], v27, s[52:55], s76 offen nt
    s_addk_i32 s76, 6912
    buffer_load_dwordx4 v[152:155], v27, s[52:55], s76 offen nt
    s_addk_i32 s76, 6912
    buffer_load_dwordx4 v[156:159], v27, s[52:55], s76 offen nt
    s_addk_i32 s76, 6912
    buffer_load_dwordx4 v[160:163], v27, s[52:55], s76 offen nt
    s_addk_i32 s76, 6912
    buffer_load_dwordx4 v[164:167], v27, s[52:55], s76 offen nt
    s_addk_i32 s76, 6912
    buffer_load_dwordx4 v[168:171], v27, s[52:55], s76 offen nt
    s_addk_i32 s76, 6912
    buffer_load_dwordx4 v[172:175], v27, s[52:55], s76 offen nt
    s_addk_i32 s76, 6912
    buffer_load_dwordx4 v[176:179], v27, s[52:55], s76 offen nt
    s_barrier
    s_lshl_b32 s13, s12, 10
    s_add_u32 s13, s13, 380928
    s_waitcnt vmcnt(20)
    v_perm_b32 v56, v180, v180, v52
    v_perm_b32 v57, v180, v180, v53
    v_perm_b32 v58, v180, v180, v54
    v_perm_b32 v59, v180, v180, v55
    s_waitcnt vmcnt(19)
    s_nop 0
    v_mfma_f32_16x16x32_bf16 v[60:63], v[56:59], v[100:103], 0
    v_perm_b32 v56, v181, v181, v52
    v_perm_b32 v57, v181, v181, v53
    v_perm_b32 v58, v181, v181, v54
    v_perm_b32 v59, v181, v181, v55
    s_waitcnt vmcnt(18)
    s_nop 0
    v_mfma_f32_16x16x32_bf16 v[60:63], v[56:59], v[104:107], v[60:63]
    v_perm_b32 v56, v182, v182, v52
    v_perm_b32 v57, v182, v182, v53
    v_perm_b32 v58, v182, v182, v54
    v_perm_b32 v59, v182, v182, v55
    s_waitcnt vmcnt(17)
    s_nop 0
    v_mfma_f32_16x16x32_bf16 v[60:63], v[56:59], v[108:111], v[60:63]
    v_perm_b32 v56, v183, v183, v52
    v_perm_b32 v57, v183, v183, v53
    v_perm_b32 v58, v183, v183, v54
    v_perm_b32 v59, v183, v183, v55
    s_waitcnt vmcnt(16)
    s_nop 0
    v_mfma_f32_16x16x32_bf16 v[60:63], v[56:59], v[112:115], v[60:63]
    v_perm_b32 v56, v184, v184, v52
    v_perm_b32 v57, v184, v184, v53
    v_perm_b32 v58, v184, v184, v54
    v_perm_b32 v59, v184, v184, v55
    s_waitcnt vmcnt(15)
    s_nop 0
    v_mfma_f32_16x16x32_bf16 v[60:63], v[56:59], v[116:119], v[60:63]
    v_perm_b32 v56, v185, v185, v52
    v_perm_b32 v57, v185, v185, v53
    v_perm_b32 v58, v185, v185, v54
    v_perm_b32 v59, v185, v185, v55
    s_waitcnt vmcnt(14)
    s_nop 0
    v_mfma_f32_16x16x32_bf16 v[60:63], v[56:59], v[120:123], v[60:63]
    v_perm_b32 v56, v186, v186, v52
    v_perm_b32 v57, v186, v186, v53
    v_perm_b32 v58, v186, v186, v54
    v_perm_b32 v59, v186, v186, v55
    s_waitcnt vmcnt(13)
    s_nop 0
    v_mfma_f32_16x16x32_bf16 v[60:63], v[56:59], v[124:127], v[60:63]
    v_perm_b32 v56, v187, v187, v52
    v_perm_b32 v57, v187, v187, v53
    v_perm_b32 v58, v187, v187, v54
    v_perm_b32 v59, v187, v187, v55
    s_waitcnt vmcnt(12)
    s_nop 0
    v_mfma_f32_16x16x32_bf16 v[60:63], v[56:59], v[128:131], v[60:63]
    v_perm_b32 v56, v188, v188, v52
    v_perm_b32 v57, v188, v188, v53
    v_perm_b32 v58, v188, v188, v54
    v_perm_b32 v59, v188, v188, v55
    s_waitcnt vmcnt(11)
    s_nop 0
    v_mfma_f32_16x16x32_bf16 v[60:63], v[56:59], v[132:135], v[60:63]
    v_perm_b32 v56, v189, v189, v52
    v_perm_b32 v57, v189, v189, v53
    v_perm_b32 v58, v189, v189, v54
    v_perm_b32 v59, v189, v189, v55
    s_waitcnt vmcnt(10)
    s_nop 0
    v_mfma_f32_16x16x32_bf16 v[60:63], v[56:59], v[136:139], v[60:63]
    v_perm_b32 v56, v190, v190, v52
    v_perm_b32 v57, v190, v190, v53
    v_perm_b32 v58, v190, v190, v54
    v_perm_b32 v59, v190, v190, v55
    s_waitcnt vmcnt(9)
    s_nop 0
    v_mfma_f32_16x16x32_bf16 v[60:63], v[56:59], v[140:143], v[60:63]
    v_perm_b32 v56, v191, v191, v52
    v_perm_b32 v57, v191, v191, v53
    v_perm_b32 v58, v191, v191, v54
    v_perm_b32 v59, v191, v191, v55
    s_waitcnt vmcnt(8)
    s_nop 0
    v_mfma_f32_16x16x32_bf16 v[60:63], v[56:59], v[144:147], v[60:63]
    v_perm_b32 v56, v192, v192, v52
    v_perm_b32 v57, v192, v192, v53
    v_perm_b32 v58, v192, v192, v54
    v_perm_b32 v59, v192, v192, v55
    s_waitcnt vmcnt(7)
    s_nop 0
    v_mfma_f32_16x16x32_bf16 v[60:63], v[56:59], v[148:151], v[60:63]
    v_perm_b32 v56, v193, v193, v52
    v_perm_b32 v57, v193, v193, v53
    v_perm_b32 v58, v193, v193, v54
    v_perm_b32 v59, v193, v193, v55
    s_waitcnt vmcnt(6)
    s_nop 0
    v_mfma_f32_16x16x32_bf16 v[60:63], v[56:59], v[152:155], v[60:63]
    v_perm_b32 v56, v194, v194, v52
    v_perm_b32 v57, v194, v194, v53
    v_perm_b32 v58, v194, v194, v54
    v_perm_b32 v59, v194, v194, v55
    s_waitcnt vmcnt(5)
    s_nop 0
    v_mfma_f32_16x16x32_bf16 v[60:63], v[56:59], v[156:159], v[60:63]
    v_perm_b32 v56, v195, v195, v52
    v_perm_b32 v57, v195, v195, v53
    v_perm_b32 v58, v195, v195, v54
    v_perm_b32 v59, v195, v195, v55
    s_waitcnt vmcnt(4)
    s_nop 0
    v_mfma_f32_16x16x32_bf16 v[60:63], v[56:59], v[160:163], v[60:63]
    v_perm_b32 v56, v196, v196, v52
    v_perm_b32 v57, v196, v196, v53
    v_perm_b32 v58, v196, v196, v54
    v_perm_b32 v59, v196, v196, v55
    s_waitcnt vmcnt(3)
    s_nop 0
    v_mfma_f32_16x16x32_bf16 v[60:63], v[56:59], v[164:167], v[60:63]
    v_perm_b32 v56, v197, v197, v52
    v_perm_b32 v57, v197, v197, v53
    v_perm_b32 v58, v197, v197, v54
    v_perm_b32 v59, v197, v197, v55
    s_waitcnt vmcnt(2)
    s_nop 0
    v_mfma_f32_16x16x32_bf16 v[60:63], v[56:59], v[168:171], v[60:63]
    v_perm_b32 v56, v198, v198, v52
    v_perm_b32 v57, v198, v198, v53
    v_perm_b32 v58, v198, v198, v54
    v_perm_b32 v59, v198, v198, v55
    s_waitcnt vmcnt(1)
    s_nop 0
    v_mfma_f32_16x16x32_bf16 v[60:63], v[56:59], v[172:175], v[60:63]
    v_perm_b32 v56, v199, v199, v52
    v_perm_b32 v57, v199, v199, v53
    v_perm_b32 v58, v199, v199, v54
    v_perm_b32 v59, v199, v199, v55
    s_waitcnt vmcnt(0)
    s_nop 0
    v_mfma_f32_16x16x32_bf16 v[60:63], v[56:59], v[176:179], v[60:63]
    s_nop 7
    v_mov_b32_sdwa v60, s43 dst_sel:BYTE_0 dst_unused:UNUSED_PRESERVE src0_sel:BYTE_0
    v_mov_b32_sdwa v61, s43 dst_sel:BYTE_0 dst_unused:UNUSED_PRESERVE src0_sel:BYTE_1
    v_mov_b32_sdwa v62, s43 dst_sel:BYTE_0 dst_unused:UNUSED_PRESERVE src0_sel:BYTE_2
    v_mov_b32_sdwa v63, s43 dst_sel:BYTE_0 dst_unused:UNUSED_PRESERVE src0_sel:BYTE_3
    s_nop 0
    buffer_store_dwordx4 v[60:63], v3, s[44:47], s13 offen
    s_cmp_eq_u32 s78, 0
    s_cbranch_scc1 L_T_n1s
    s_add_u32 s13, s13, 4194304
    buffer_store_dwordx4 v[60:63], v3, s[44:47], s13 offen sc1
L_T_n1s:
    s_mov_b32 s79, 1
L_T_n1done:
    v_and_b32 v32, 1, v1
    v_lshlrev_b32 v32, 4, v32
    v_mov_b32 v33, 0xffff
    v_lshlrev_b32 v32, v32, v33
    v_lshrrev_b32 v33, 1, v1
    v_cmp_eq_u32 vcc, 0, v33
    s_nop 1
    v_cndmask_b32 v24, 0, v32, vcc
    v_cmp_eq_u32 vcc, 1, v33
    s_nop 1
    v_cndmask_b32 v25, 0, v32, vcc
    v_cmp_eq_u32 vcc, 2, v33
    s_nop 1
    v_cndmask_b32 v26, 0, v32, vcc
    v_cmp_eq_u32 vcc, 3, v33
    s_nop 1
    v_cndmask_b32 v27, 0, v32, vcc
    s_lshl3_add_u32 s13, s12, s3
    s_lshl_b32 s13, s13, 10
    s_add_u32 s13, s13, 2097152
    s_lshl_b32 s7, s3, 4
    v_lshl_add_u32 v7, v2, 2, s7
    s_mul_i32 s7, s3, 320
    v_lshrrev_b32 v28, 1, v1
    v_lshl_add_u32 v28, v28, 5, s7
    v_and_b32 v29, 1, v1
    v_lshl_add_u32 v28, v29, 3, v28
    v_lshl_add_u32 v28, v2, 2, v28
    v_lshrrev_b32 v17, 2, v1
    v_lshl_add_u32 v29, v17, 1, v29
    v_mul_u32_u24 v29, 320, v29
    v_lshl_add_u32 v29, v2, 5, v29
    v_and_b32 v17, 2, v1
    v_lshl_add_u32 v29, v17, 3, v29
    v_add_u32 v28, 38400, v28
    v_bfe_u32 v17, v0, 1, 1
    v_mul_u32_u24 v17, 0xaaaa, v17
    v_add_u32 v17, 0x4444, v17
    v_mov_b32 v48, 0
    v_mov_b32 v49, 0
    v_mov_b32 v50, 0
    v_mov_b32 v51, 0
    v_and_b32 v6, 3, v0
    v_mul_u32_u24 v30, 2112, v2
    v_bfe_u32 v18, v0, 2, 2
    v_lshl_add_u32 v30, v18, 8, v30
    v_lshl_add_u32 v30, v6, 3, v30
    s_lshl_b32 s7, s3, 5
    s_add_u32 s7, s7, 45056
    v_add_u32 v30, s7, v30
    v_lshlrev_b32 v19, 2, v0
    v_lshlrev_b32 v23, 3, v6
    v_lshrrev_b32 v23, v23, s43
    v_or_b32 v23, 1, v23
    v_mov_b32 v18, 0xff
    s_lshl_b32 s72, s6, 9
    s_add_u32 s72, s72, 348160
    s_cmp_lg_u32 s79, 0
    s_cbranch_scc1 L_T_nw
    s_waitcnt vmcnt(0)
L_T_nw:
    s_cmp_lg_u32 s3, 6
    s_cbranch_scc1 L_11
    v_lshlrev_b32 v6, 8, v0
    s_lshr_b32 s7, s6, 3
    s_lshl_b32 s7, s7, 13
    s_bfe_u32 s8, s6, 0x10002
    s_lshl_b32 s8, s8, 7
    s_add_u32 s7, s7, s8
    s_and_b32 s8, s6, 3
    s_lshl4_add_u32 s7, s8, s7
    s_add_u32 s7, s7, 315392
    s_mov_b32 exec_hi, 0
    s_mov_b32 s66, 0
L_poll_12:
    buffer_load_dwordx4 v[52:55], v6, s[44:47], s7 offen sc1
    s_add_u32 s66, s66, 1
    s_cmp_ge_u32 s66, 131072
    s_cbranch_scc1 L_end
    s_waitcnt vmcnt(0)
    v_cmp_ne_u32 vcc, s43, v55
    s_cbranch_vccnz L_poll_12
    s_barrier
    buffer_load_dwordx4 v[56:59], v3, s[44:47], s72 offen sc1
    s_mov_b32 exec_hi, -1
    s_branch L_T_go
L_11:
    s_barrier
L_T_go:
    buffer_load_dwordx4 v[8:11], v3, s[44:47], s13 offen sc1
    s_mov_b32 s79, 0
    ds_read_b64_tr_b16 v[64:65], v30 offset:0
    ds_read_b64_tr_b16 v[66:67], v30 offset:1056
    ds_read_b64_tr_b16 v[68:69], v30 offset:8448
    ds_read_b64_tr_b16 v[70:71], v30 offset:9504
    ds_read_b64_tr_b16 v[72:73], v30 offset:16896
    ds_read_b64_tr_b16 v[74:75], v30 offset:17952
    ds_read_b64_tr_b16 v[76:77], v30 offset:25344
    ds_read_b64_tr_b16 v[78:79], v30 offset:26400
    s_cmp_lg_u32 s3, 6
    s_cbranch_scc1 L_13
    v_mov_b32 v54, v52
    s_nop 1
    v_max_f32_dpp v54, v54, v54 row_ror:8 row_mask:0xf bank_mask:0xf
    s_nop 1
    v_max_f32_dpp v54, v54, v54 row_ror:4 row_mask:0xf bank_mask:0xf
    s_nop 1
    v_max_f32_dpp v54, v54, v54 row_ror:2 row_mask:0xf bank_mask:0xf
    s_nop 1
    v_max_f32_dpp v54, v54, v54 row_ror:1 row_mask:0xf bank_mask:0xf
    v_mov_b32 v55, v54
    s_nop 1
    v_permlane16_swap_b32 v54, v55
    v_max_f32 v54, v54, v55
    v_sub_f32 v52, v52, v54
    v_exp_f32 v52, v52
    s_nop 0
    v_cvt_pk_bf16_f32 v52, v52, v52
    ds_write_b32 v19, v52 offset:37888
    v_and_b32 v53, 0xffff0000, v52
L_13:
    s_waitcnt lgkmcnt(0)
    s_barrier
    ds_read_b32 v16, v7 offset:37888
    s_waitcnt lgkmcnt(0)
    v_and_b32 v12, v16, v24
    v_and_b32 v13, v16, v25
    v_and_b32 v14, v16, v26
    v_and_b32 v15, v16, v27
    s_cmp_lg_u32 s3, 6
    s_cbranch_scc1 L_14
    s_mov_b32 exec_hi, 0
    s_waitcnt vmcnt(1)
    v_cmp_ne_u32 vcc, s43, v59
    s_cbranch_vccz L_T_lnow
    buffer_load_dwordx4 v[56:59], v3, s[44:47], s72 offen sc1
    s_mov_b32 s79, 1
    s_mov_b32 exec_hi, -1
    s_branch L_T_ldone
L_T_lnow:
    s_mov_b32 exec_hi, -1
    v_mul_f32 v56, v56, v53
    s_nop 1
    v_add_f32_dpp v56, v56, v56 row_ror:8 row_mask:0xf bank_mask:0xf
    s_nop 1
    v_add_f32_dpp v56, v56, v56 row_ror:4 row_mask:0xf bank_mask:0xf
    s_nop 1
    v_add_f32_dpp v56, v56, v56 row_ror:2 row_mask:0xf bank_mask:0xf
    s_nop 1
    v_add_f32_dpp v56, v56, v56 row_ror:1 row_mask:0xf bank_mask:0xf
    s_nop 1
    v_permlane16_swap_b32 v56, v57
    v_add_f32 v56, v56, v57
    v_rcp_f32 v56, v56
    s_nop 0
    v_bfi_b32 v56, v18, v23, v56
    s_mov_b64 exec, 0xffff
    buffer_store_dword v56, v19, s[44:47], s73 offen
    s_mov_b64 exec, -1
L_T_ldone:
    s_mov_b32 s66, 0
    s_waitcnt vmcnt(1)
    s_branch L_T_chk
L_14:
    s_mov_b32 s66, 0
    s_branch L_wait_16
L_retry_15:
    buffer_load_dwordx4 v[8:11], v3, s[44:47], s13 offen sc1
    s_add_u32 s66, s66, 1
    s_cmp_ge_u32 s66, 131072
    s_cbranch_scc1 L_end
L_wait_16:
    s_waitcnt vmcnt(0)
L_T_chk:
    v_mfma_f32_16x16x32_bf16 v[32:35], v[12:15], v[8:11], 0
    v_cmp_eq_u32 vcc, -1, v11
    s_cbranch_vccnz L_retry_15
    s_mov_b32 exec_hi, 0
    s_nop 4
    v_cvt_pk_bf16_f32 v20, v32, v33
    v_cvt_pk_bf16_f32 v21, v34, v35
    ds_write2_b32 v28, v20, v21 offset1:4
    s_mov_b32 exec_hi, -1
    s_waitcnt lgkmcnt(0)
    s_barrier
    ds_read_b128 v[32:35], v29 offset:38400
    ds_read_b128 v[36:39], v29 offset:38528
    s_cmp_lg_u32 s79, 0
    s_cbranch_scc1 L_T_w6
    s_waitcnt lgkmcnt(1)
    v_smfmac_f32_16x16x64_bf16 v[48:51], v[32:35], v[64:71], v17
    s_waitcnt lgkmcnt(0)
    v_smfmac_f32_16x16x64_bf16 v[48:51], v[36:39], v[72:79], v17
    s_nop 7
L_T_tail:
    v_pk_add_f32 v[48:49], v[48:49], v[50:51]
    v_add_f32 v48, v48, v49
    s_nop 1
    v_permlane32_swap_b32 v48, v49
    v_add_f32 v48, v48, v49
    s_nop 1
    v_permlane16_swap_b32 v48, v49
    v_add_f32 v48, v48, v49
    v_bfi_b32 v48, v18, v23, v48
    s_mov_b64 exec, 0xffff
    buffer_store_dword v48, v31, s[44:47], s15 offen
    s_lshl3_add_u32 s7, s5, s3
    s_cmp_lg_u32 s7, 5
    s_cbranch_scc1 L_17
    s_lshl_b32 s7, s6, 7
    s_add_u32 s7, s7, 364544
    v_mov_b32 v16, s43
    s_waitcnt vmcnt(0)
    s_mov_b64 exec, 1
    buffer_store_dword v16, v0, s[44:47], s7 offen sc1
    s_mov_b64 exec, 0xffff
L_17:
    s_cmp_eq_u32 s78, 0
    s_cbranch_scc1 L_T_fin
    buffer_store_dword v48, v31, s[44:47], s74 offen sc1
    s_cmp_lg_u32 s3, 6
    s_cbranch_scc1 L_T_fin
    buffer_store_dword v56, v19, s[44:47], s75 offen sc1
    s_branch L_T_fin
L_T_w6:
    s_mov_b32 exec_hi, 0
    s_mov_b32 s66, 0
    s_branch L_wait_19
L_retry_18:
    buffer_load_dwordx4 v[56:59], v3, s[44:47], s72 offen sc1
    s_add_u32 s66, s66, 1
    s_cmp_ge_u32 s66, 131072
    s_cbranch_scc1 L_end
L_wait_19:
    s_waitcnt vmcnt(0)
L_chk_20:
    v_cmp_ne_u32 vcc, s43, v59
    s_cbranch_vccnz L_retry_18
    s_mov_b32 exec_hi, -1
    v_mul_f32 v56, v56, v53
    s_waitcnt lgkmcnt(1)
    v_smfmac_f32_16x16x64_bf16 v[48:51], v[32:35], v[64:71], v17
    v_add_f32_dpp v56, v56, v56 row_ror:8 row_mask:0xf bank_mask:0xf
    s_waitcnt lgkmcnt(0)
    v_smfmac_f32_16x16x64_bf16 v[48:51], v[36:39], v[72:79], v17
    v_add_f32_dpp v56, v56, v56 row_ror:4 row_mask:0xf bank_mask:0xf
    s_nop 1
    v_add_f32_dpp v56, v56, v56 row_ror:2 row_mask:0xf bank_mask:0xf
    s_nop 1
    v_add_f32_dpp v56, v56, v56 row_ror:1 row_mask:0xf bank_mask:0xf
    s_nop 1
    v_permlane16_swap_b32 v56, v57
    v_add_f32 v56, v56, v57
    v_rcp_f32 v56, v56
    s_nop 0
    v_bfi_b32 v56, v18, v23, v56
    s_mov_b64 exec, 0xffff
    buffer_store_dword v56, v19, s[44:47], s73 offen
    s_mov_b64 exec, -1
    s_branch L_T_tail
L_T_fin:
    s_mov_b64 exec, -1
    s_cmp_lg_u32 s3, 0
    s_cbranch_scc1 L_end
    s_cmp_gt_u32 s12, 80
    s_cbranch_scc1 L_end
    s_mov_b64 s[56:57], s[36:37]
    s_mov_b32 s58, 1280
    s_mov_b32 s59, 0x20000
    v_lshrrev_b32 v5, 1, v0
    v_mul_u32_u24 v5, 2560, v5
    v_and_b32 v6, 1, v0
    v_lshl_add_u32 v5, v6, 4, v5
    v_lshlrev_b32 v7, 7, v0
    v_lshl_add_u32 v6, v6, 2, v2
    v_lshlrev_b32 v6, 1, v6
    s_lshl_b32 s7, s12, 5
    s_add_u32 s76, s7, 610304
    s_add_u32 s77, s7, 692224
    s_add_u32 s78, s7, 774144
    s_add_u32 s79, s7, 856064
    s_lshl_b32 s13, s12, 4
    s_mov_b32 s14, 364544
    s_mov_b32 exec_hi, 0
    s_mov_b32 s66, 0
L_poll_21:
    buffer_load_dword v8, v7, s[44:47], s14 offen sc1
    s_add_u32 s66, s66, 1
    s_cmp_ge_u32 s66, 131072
    s_cbranch_scc1 L_end
    s_waitcnt vmcnt(0)
    v_cmp_ne_u32 vcc, s43, v8
    s_cbranch_vccnz L_poll_21
    s_mov_b32 exec_hi, -1
    s_cmp_eq_u32 s12, 80
    s_cbranch_scc1 L_epoch
    s_mov_b32 s66, 0
L_R_again:
    buffer_load_dwordx4 v[32:35], v5, s[44:47], s76 offen sc1
    buffer_load_dwordx4 v[36:39], v5, s[44:47], s77 offen sc1
    buffer_load_dwordx4 v[40:43], v5, s[44:47], s78 offen sc1
    buffer_load_dwordx4 v[44:47], v5, s[44:47], s79 offen sc1
    s_add_u32 s66, s66, 1
    s_cmp_ge_u32 s66, 131072
    s_cbranch_scc1 L_end
    s_waitcnt vmcnt(2)
    v_max_u32 v48, v35, v39
    v_pk_add_f32 v[32:33], v[32:33], v[36:37]
    v_pk_add_f32 v[34:35], v[34:35], v[38:39]
    s_waitcnt vmcnt(1)
    v_pk_add_f32 v[32:33], v[32:33], v[40:41]
    v_pk_add_f32 v[34:35], v[34:35], v[42:43]
    s_waitcnt vmcnt(0)
    v_pk_add_f32 v[32:33], v[32:33], v[44:45]
    v_pk_add_f32 v[34:35], v[34:35], v[46:47]
    v_max3_u32 v48, v48, v43, v47
    v_cmp_eq_u32 vcc, -1, v48
    v_permlane32_swap_b32 v32, v34
    v_permlane32_swap_b32 v33, v35
    v_add_f32 v32, v32, v34
    v_add_f32 v33, v33, v35
    s_nop 1
    v_permlane16_swap_b32 v32, v33
    v_add_f32 v32, v32, v33
    s_cbranch_vccnz L_R_again
    s_nop 0
    v_add_f32_dpp v32, v32, v32 row_ror:2 row_mask:0xf bank_mask:0xf
    s_nop 1
    v_add_f32_dpp v32, v32, v32 row_ror:4 row_mask:0xf bank_mask:0xf
    s_nop 1
    v_add_f32_dpp v32, v32, v32 row_ror:8 row_mask:0xf bank_mask:0xf
    v_cvt_pk_bf16_f32 v25, v32, v32
    s_mov_b32 exec_lo, 0x00030003
    s_mov_b32 exec_hi, 0x00030003
    buffer_store_short v25, v6, s[56:59], s13 offen
    s_branch L_end
L_epoch:
    s_mov_b32 s14, 0
    v_mov_b32 v16, s43
    s_mov_b64 exec, 1
    buffer_store_dword v16, v0, s[44:47], s14 offen sc1
    s_mov_b64 exec, -1
    s_branch L_end
L_B_qk:
    s_load_dword s42, s[44:45], 0
    s_load_dwordx8 s[32:39], s[0:1], 64
    s_mov_b32 s46, 16777216
    s_mov_b32 s47, 0x20000
    s_lshl2_add_u32 s12, s6, s5
    v_mul_u32_u24 v6, 1056, v1
    v_lshl_add_u32 v6, v2, 4, v6
    s_mul_i32 s10, s15, 33792
    v_add_u32 v7, s10, v6
    s_add_u32 s60, s10, 33792
    v_mul_u32_u24 v4, 1280, v2
    v_add_u32 v4, v4, v5
    s_lshl2_add_u32 s10, s12, s15
    s_mul_i32 s72, s10, 5120
    s_mul_i32 s10, s10, 10240
    s_add_u32 s11, s10, 2560
    v_and_b32 v23, 1, v2
    v_lshrrev_b32 v21, 1, v2
    v_lshl_add_u32 v23, v23, 2, v21
    v_mul_u32_u24 v23, 1280, v23
    v_add_u32 v23, v23, v5
    v_lshlrev_b32 v20, 3, v2
    v_add_u32 v20, 143872, v20
    s_lshl_b32 s7, s15, 9
    s_add_u32 s7, s7, 144384
    v_lshl_add_u32 v22, v2, 6, s7
    v_and_b32 v21, 8, v1
    v_lshl_add_u32 v22, v21, 5, v22
    v_and_b32 v21, 2, v1
    v_lshl_add_u32 v22, v21, 4, v22
    v_and_b32 v21, 5, v1
    v_lshl_add_u32 v22, v21, 1, v22
    v_lshrrev_b32 v6, 2, v1
    v_and_b32 v21, 1, v1
    v_lshl_add_u32 v6, v6, 1, v21
    v_mul_u32_u24 v6, 1088, v6
    v_lshl_add_u32 v6, v2, 5, v6
    v_and_b32 v21, 2, v1
    v_lshl_add_u32 v6, v21, 3, v6
    v_add_u32 v6, 135168, v6
    v_bfe_u32 v21, v0, 1, 1
    v_mul_u32_u24 v21, 0xaaaa, v21
    v_add_u32 v21, 0x4444, v21
    v_mov_b32 v96, 0
    v_mov_b32 v97, 0
    v_mov_b32 v98, 0
    v_mov_b32 v99, 0
    v_mov_b32 v100, 0
    v_mov_b32 v101, 0
    v_mov_b32 v102, 0
    v_mov_b32 v103, 0
    s_lshl_b32 s77, s5, 12
    s_lshl4_add_u32 s77, s6, s77
    s_add_u32 s77, s77, 348160
    s_mov_b32 s64, 0x0c0c0400
    s_mov_b32 s65, 0x04000c0c
    s_lshl3_add_u32 s7, s5, s3
    s_lshl_b32 s13, s7, 10
    s_add_u32 s13, s13, 266240
    s_mul_i32 s7, s3, 1088
    s_add_u32 s7, s7, 135168
    v_add_u32 v17, s7, v3
    s_waitcnt lgkmcnt(0)
    s_add_u32 s43, s42, 0x9E3779B1
    s_mov_b64 s[52:53], s[26:27]
    s_mov_b32 s54, 5242880
    s_mov_b32 s55, 0x20000
    s_mov_b64 s[56:57], s[32:33]
    s_mov_b32 s58, 2211840
    s_mov_b32 s59, 0x20000
    s_waitcnt vmcnt(3)
L_B_dma2:
    s_mov_b32 m0, s61
    s_lshl_b32 s9, s62, 10
    s_add_u32 s9, s9, s63
    buffer_load_dwordx4 v3, s[48:51], s9 offen lds
    s_add_u32 s62, s62, 1
    s_and_b32 s62, s62, 31
    s_addk_i32 s61, 1056
    s_cmp_lt_u32 s61, s60
    s_cbranch_scc1 L_B_dma2
    s_waitcnt vmcnt(16)
    s_barrier
    ds_read_b128 v[128:131], v7 offset:0
    ds_read_b128 v[132:135], v7 offset:64
    ds_read_b128 v[136:139], v7 offset:128
    ds_read_b128 v[140:143], v7 offset:192
    ds_read_b128 v[144:147], v7 offset:256
    ds_read_b128 v[148:151], v7 offset:320
    ds_read_b128 v[152:155], v7 offset:384
    ds_read_b128 v[156:159], v7 offset:448
    ds_read_b128 v[160:163], v7 offset:512
    ds_read_b128 v[164:167], v7 offset:576
    ds_read_b128 v[168:171], v7 offset:640
    ds_read_b128 v[172:175], v7 offset:704
    ds_read_b128 v[176:179], v7 offset:768
    ds_read_b128 v[180:183], v7 offset:832
    ds_read_b128 v[184:187], v7 offset:896
    ds_read_b128 v[188:191], v7 offset:960
    s_waitcnt vmcnt(0)
    s_setprio 3
    s_barrier
    buffer_load_dwordx4 v[8:11], v3, s[44:47], s13 offen sc1
    ds_read_b128 v[192:195], v7 offset:16896
    ds_read_b128 v[196:199], v7 offset:16960
    ds_read_b128 v[200:203], v7 offset:17024
    ds_read_b128 v[204:207], v7 offset:17088
    ds_read_b128 v[208:211], v7 offset:17152
    ds_read_b128 v[212:215], v7 offset:17216
    ds_read_b128 v[216:219], v7 offset:17280
    ds_read_b128 v[220:223], v7 offset:17344
    ds_read_b128 v[224:227], v7 offset:17408
    ds_read_b128 v[228:231], v7 offset:17472
    ds_read_b128 v[232:235], v7 offset:17536
    ds_read_b128 v[236:239], v7 offset:17600
    ds_read_b128 v[240:243], v7 offset:17664
    ds_read_b128 v[244:247], v7 offset:17728
    ds_read_b128 v[248:251], v7 offset:17792
    ds_read_b128 v[252:255], v7 offset:17856
    buffer_load_dwordx4 v[104:107], v4, s[56:59], s72 offen offset:0 nt
    buffer_load_dwordx4 v[108:111], v4, s[56:59], s72 offen offset:256 nt
    buffer_load_dwordx4 v[112:115], v4, s[56:59], s72 offen offset:512 nt
    buffer_load_dwordx4 v[116:119], v4, s[56:59], s72 offen offset:768 nt
    s_mov_b32 s66, 0
    s_waitcnt vmcnt(4)
    s_branch L_chk_24
L_retry_22:
    buffer_load_dwordx4 v[8:11], v3, s[44:47], s13 offen sc1
    s_add_u32 s66, s66, 1
    s_cmp_ge_u32 s66, 131072
    s_cbranch_scc1 L_end
L_wait_23:
    s_waitcnt vmcnt(0)
L_chk_24:
    ds_write_b128 v17, v[8:11]
    v_cmp_eq_u32 vcc, -1, v11
    s_cbranch_vccnz L_retry_22
    s_waitcnt lgkmcnt(0)
    s_barrier
    ds_read_b128 v[64:67], v6 offset:0
    ds_read_b128 v[68:71], v6 offset:128
    ds_read_b128 v[72:75], v6 offset:256
    ds_read_b128 v[76:79], v6 offset:384
    s_waitcnt lgkmcnt(3)
    v_smfmac_f32_16x16x64_bf16 v[96:99], v[64:67], v[128:135], v21
    ds_read_b128 v[80:83], v6 offset:512
    v_smfmac_f32_16x16x64_bf16 v[100:103], v[64:67], v[192:199], v21
    s_waitcnt lgkmcnt(3)
    v_smfmac_f32_16x16x64_bf16 v[96:99], v[68:71], v[136:143], v21
    ds_read_b128 v[84:87], v6 offset:640
    v_smfmac_f32_16x16x64_bf16 v[100:103], v[68:71], v[200:207], v21
    buffer_load_dwordx4 v[120:123], v4, s[56:59], s72 offen offset:1024 nt
    s_waitcnt lgkmcnt(3)
    v_smfmac_f32_16x16x64_bf16 v[96:99], v[72:75], v[144:151], v21
    ds_read_b128 v[88:91], v6 offset:768
    v_smfmac_f32_16x16x64_bf16 v[100:103], v[72:75], v[208:215], v21
    buffer_load_dwordx4 v[24:27], v23, s[52:55], s10 offen offset:0 nt
    s_waitcnt lgkmcnt(3)
    v_smfmac_f32_16x16x64_bf16 v[96:99], v[76:79], v[152:159], v21
    ds_read_b128 v[92:95], v6 offset:896
    v_smfmac_f32_16x16x64_bf16 v[100:103], v[76:79], v[216:223], v21
    buffer_load_dwordx4 v[32:35], v23, s[52:55], s10 offen offset:256 nt
    s_waitcnt lgkmcnt(3)
    v_smfmac_f32_16x16x64_bf16 v[96:99], v[80:83], v[160:167], v21
    v_smfmac_f32_16x16x64_bf16 v[100:103], v[80:83], v[224:231], v21
    s_waitcnt lgkmcnt(2)
    v_smfmac_f32_16x16x64_bf16 v[96:99], v[84:87], v[168:175], v21
    v_smfmac_f32_16x16x64_bf16 v[100:103], v[84:87], v[232:239], v21
    s_waitcnt lgkmcnt(1)
    v_smfmac_f32_16x16x64_bf16 v[96:99], v[88:91], v[176:183], v21
    v_smfmac_f32_16x16x64_bf16 v[100:103], v[88:91], v[240:247], v21
    s_waitcnt lgkmcnt(0)
    v_smfmac_f32_16x16x64_bf16 v[96:99], v[92:95], v[184:191], v21
    v_smfmac_f32_16x16x64_bf16 v[100:103], v[92:95], v[248:255], v21
    s_nop 6
    v_pk_add_f32 v[8:9], v[96:97], v[98:99]
    v_pk_add_f32 v[10:11], v[100:101], v[102:103]
    v_max_f32 v12, v8, v10
    v_max_f32 v13, v9, v11
    s_nop 0
    v_max_f32_dpp v12, v12, v12 row_ror:8 row_mask:0xf bank_mask:0xf
    v_max_f32_dpp v13, v13, v13 row_ror:8 row_mask:0xf bank_mask:0xf
    s_nop 0
    v_max_f32_dpp v12, v12, v12 row_ror:4 row_mask:0xf bank_mask:0xf
    v_max_f32_dpp v13, v13, v13 row_ror:4 row_mask:0xf bank_mask:0xf
    s_nop 0
    v_max_f32_dpp v12, v12, v12 row_ror:2 row_mask:0xf bank_mask:0xf
    v_max_f32_dpp v13, v13, v13 row_ror:2 row_mask:0xf bank_mask:0xf
    s_nop 0
    v_max_f32_dpp v12, v12, v12 row_ror:1 row_mask:0xf bank_mask:0xf
    v_max_f32_dpp v13, v13, v13 row_ror:1 row_mask:0xf bank_mask:0xf
    s_mov_b32 exec_lo, 65537
    s_mov_b32 exec_hi, 65537
    ds_max_f32 v20, v12
    ds_max_f32 v20, v13 offset:4
    s_mov_b64 exec, -1
    s_waitcnt lgkmcnt(0)
    s_barrier
    ds_read_b64 v[12:13], v20
    s_waitcnt lgkmcnt(0)
    v_pk_add_f32 v[8:9], v[8:9], v[12:13] neg_lo:[0,1] neg_hi:[0,1]
    v_pk_add_f32 v[10:11], v[10:11], v[12:13] neg_lo:[0,1] neg_hi:[0,1]
    v_exp_f32 v8, v8
    v_exp_f32 v9, v9
    v_exp_f32 v10, v10
    v_cvt_pk_bf16_f32 v16, v8, v9
    v_exp_f32 v11, v11
    ds_write_b16 v22, v16
    ds_write_b16_d16_hi v22, v16 offset:16
    v_cvt_pk_bf16_f32 v17, v10, v11
    ds_write_b16 v22, v17 offset:4
    ds_write_b16_d16_hi v22, v17 offset:20
    s_waitcnt lgkmcnt(0)
    s_barrier
    s_setprio 0
    s_cmp_lg_u32 s3, 7
    s_cbranch_scc1 L_25
    v_add_u32 v9, 144384, v3
    ds_read_b128 v[64:67], v9 offset:0
    ds_read_b128 v[68:71], v9 offset:1024
    v_mov_b32 v8, 0x3f803f80
    v_mov_b32 v99, s43
    v_lshrrev_b32 v10, 1, v0
    v_and_b32 v11, 1, v0
    v_add_lshl_u32 v10, v10, v11, 9
    s_waitcnt lgkmcnt(0)
    v_dot2_f32_bf16 v96, v64, v8, 0
    v_dot2_f32_bf16 v96, v65, v8, v96
    v_dot2_f32_bf16 v96, v66, v8, v96
    v_dot2_f32_bf16 v96, v67, v8, v96
    v_dot2_f32_bf16 v96, v68, v8, v96
    v_dot2_f32_bf16 v96, v69, v8, v96
    v_dot2_f32_bf16 v96, v70, v8, v96
    v_dot2_f32_bf16 v96, v71, v8, v96
    s_nop 2
    v_add_f32_dpp v96, v96, v96 quad_perm:[2,3,0,1] row_mask:0xf bank_mask:0xf
    v_mov_b32 v9, v96
    s_nop 1
    v_permlane16_swap_b32 v96, v9
    v_add_f32 v96, v96, v9
    v_mov_b32 v9, v96
    s_nop 1
    v_permlane32_swap_b32 v96, v9
    v_add_f32 v96, v96, v9
    s_mov_b64 exec, 0x3333
    buffer_store_dwordx4 v[96:99], v10, s[44:47], s77 offen sc1
    s_mov_b64 exec, -1
L_25:
    buffer_load_dwordx4 v[40:43], v23, s[52:55], s10 offen offset:512 nt
    buffer_load_dwordx4 v[48:51], v23, s[52:55], s10 offen offset:768 nt
    v_and_b32 v68, 1, v1
    v_lshlrev_b32 v68, 4, v68
    v_mov_b32 v69, 0xffff
    v_lshlrev_b32 v68, v68, v69
    v_lshrrev_b32 v69, 1, v1
    v_cmp_eq_u32 vcc, 0, v69
    s_nop 1
    v_cndmask_b32 v64, 0, v68, vcc
    v_cmp_eq_u32 vcc, 2, v69
    s_nop 1
    v_cndmask_b32 v65, 0, v68, vcc
    v_cmp_eq_u32 vcc, 4, v69
    s_nop 1
    v_cndmask_b32 v66, 0, v68, vcc
    v_cmp_eq_u32 vcc, 6, v69
    s_nop 1
    v_cndmask_b32 v67, 0, v68, vcc
    v_and_b32 v18, 10, v1
    v_mov_b32 v19, 0xffff
    v_cmp_eq_u32 vcc, 0, v18
    s_nop 1
    v_cndmask_b32 v124, 0, v19, vcc
    v_cmp_eq_u32 vcc, 8, v18
    s_nop 1
    v_cndmask_b32 v125, 0, v19, vcc
    v_bfe_u32 v18, v1, 2, 1
    v_and_b32 v19, 1, v1
    v_lshl_add_u32 v18, v18, 1, v19
    v_mul_u32_u24 v126, 0x1111, v18
    v_mov_b32 v9, 148480
    ds_read_b32 v12, v9
    v_lshlrev_b32 v6, 2, v1
    v_mul_u32_u24 v7, 28, v2
    v_add_u32 v6, v6, v7
    s_mul_i32 s13, s12, 640
    s_add_u32 s13, s13, 512000
    v_lshl_add_u32 v6, s15, 7, v6
    v_and_b32 v7, 1, v0
    v_mov_b32 v13, 512
    v_cmp_le_u32 vcc, 8, v1
    s_nop 1
    v_cndmask_b32 v6, v6, v13, vcc
    v_lshl_add_u32 v6, v2, 2, v6
    s_lshl_b32 s69, s6, 7
    s_add_u32 s69, s69, 364544
    v_lshrrev_b32 v13, 1, v0
    v_lshlrev_b32 v13, 10, v13
    v_mul_u32_u24 v7, 640, v7
    v_add_u32 v13, v13, v7
    s_lshl_b32 s14, s6, 12
    s_lshl_b32 s7, s5, 5
    s_add_u32 s14, s14, s7
    s_lshr_b32 s7, s15, 1
    s_lshl4_add_u32 s14, s7, s14
    s_and_b32 s7, s15, 1
    s_lshl_b32 s7, s7, 8
    s_add_u32 s14, s14, s7
    s_add_u32 s14, s14, 380928
    v_mul_u32_u24 v7, 160, v2
    v_lshl_add_u32 v7, v1, 3, v7
    s_mul_i32 s7, s15, 3200
    v_add_u32 v7, s7, v7
    s_lshl_b32 s7, s15, 10
    v_add_u32 v14, s7, v3
    v_lshrrev_b32 v100, 5, v0
    v_lshl_add_u32 v100, s15, 1, v100
    v_mul_u32_u24 v100, 640, v100
    v_and_b32 v22, 1, v0
    v_mul_u32_u24 v22, 320, v22
    v_add_u32 v100, v100, v22
    v_bfe_u32 v22, v0, 1, 4
    v_lshl_add_u32 v100, v22, 3, v100
    v_add_u32 v101, 3200, v100
    v_add_u32 v102, 6400, v100
    v_add_u32 v103, 9600, v100
    s_mul_i32 s8, s12, 2560
    s_add_u32 s8, s8, 610304
    v_mov_b32 v15, s43
    v_mov_b32 v8, 0
    v_mov_b32 v9, 0
    v_mov_b32 v10, 0
    v_mov_b32 v11, 0
    ds_write_b32 v8, v8 offset:16384
    s_waitcnt lgkmcnt(0)
    s_barrier
    s_cmp_ge_u32 s6, 27
    s_cbranch_scc1 L_B_nfa
    s_mov_b64 exec, 0xff
    buffer_load_dwordx4 v[8:11], v13, s[44:47], s14 offen sc1
    s_mov_b64 exec, -1
L_B_nfa:
    buffer_load_dwordx4 v[56:59], v23, s[52:55], s10 offen offset:1024 nt
    buffer_load_dwordx4 v[28:31], v23, s[52:55], s11 offen offset:0 nt
    buffer_load_dwordx4 v[36:39], v23, s[52:55], s11 offen offset:256 nt
    buffer_load_dwordx4 v[44:47], v23, s[52:55], s11 offen offset:512 nt
    buffer_load_dwordx4 v[52:55], v23, s[52:55], s11 offen offset:768 nt
    buffer_load_dwordx4 v[60:63], v23, s[52:55], s11 offen offset:1024 nt
    s_waitcnt vmcnt(6)
    s_cmp_ge_u32 s6, 27
    s_cbranch_scc1 L_B_faok
    s_mov_b64 exec, 0xff
    s_mov_b32 s66, 0
    s_waitcnt vmcnt(6)
    s_branch L_chk_28
L_retry_26:
    buffer_load_dwordx4 v[8:11], v13, s[44:47], s14 offen sc1
    s_add_u32 s66, s66, 1
    s_cmp_ge_u32 s66, 48
    s_cselect_b32 s67, 4194304, 0
    s_xor_b32 s14, s14, s67
    s_cmp_ge_u32 s66, 131072
    s_cbranch_scc1 L_end
L_wait_27:
    s_waitcnt vmcnt(0)
L_chk_28:
    v_perm_b32 v16, v9, v8, s64
    v_perm_b32 v17, v11, v10, s65
    v_or_b32 v16, v16, v17
    v_cmp_ne_u32 vcc, s43, v16
    s_cbranch_vccnz L_retry_26
    s_mov_b64 exec, -1
L_B_faok:
    v_permlane32_swap_b32 v8, v10
    v_permlane32_swap_b32 v9, v11
    v_add_f32 v8, v8, v10
    v_add_f32 v9, v9, v11
    s_nop 1
    v_permlane16_swap_b32 v8, v9
    v_add_f32 v8, v8, v9
    s_nop 1
    v_add_f32_dpp v8, v8, v8 row_ror:1 row_mask:0xf bank_mask:0xf
    s_nop 1
    v_add_f32_dpp v8, v8, v8 row_ror:2 row_mask:0xf bank_mask:0xf
    s_nop 1
    v_add_f32_dpp v8, v8, v8 row_ror:4 row_mask:0xf bank_mask:0xf
    s_nop 1
    v_add_f32_dpp v8, v8, v8 row_ror:8 row_mask:0xf bank_mask:0xf
    v_mul_f32 v9, 3216550459, v8
    v_exp_f32 v9, v9
    s_nop 0
    v_add_f32 v9, 1.0, v9
    v_rcp_f32 v9, v9
    v_sub_f32 v10, 1.0, v12
    v_mul_f32 v8, v8, v9
    v_mul_f32 v8, v8, v10
    v_cvt_pk_bf16_f32 v8, v8, v8
    v_and_b32 v68, v8, v64
    v_and_b32 v69, v8, v65
    v_and_b32 v70, v8, v66
    v_and_b32 v71, v8, v67
    s_nop 1
    v_mfma_f32_16x16x32_bf16 v[76:79], v[68:71], v[104:107], 0
    v_mfma_f32_16x16x32_bf16 v[80:83], v[68:71], v[108:111], 0
    v_mfma_f32_16x16x32_bf16 v[84:87], v[68:71], v[112:115], 0
    v_mfma_f32_16x16x32_bf16 v[88:91], v[68:71], v[116:119], 0
    v_mfma_f32_16x16x32_bf16 v[92:95], v[68:71], v[120:123], 0
    v_lshlrev_b32 v13, 3, v2
    v_lshrrev_b32 v13, v13, s43
    v_or_b32 v13, 1, v13
    v_mov_b32 v11, 1
    s_mov_b32 exec_lo, 0x01ff01ff
    s_mov_b32 exec_hi, 0x01ff01ff
    s_mov_b32 s66, 0
L_poll_29:
    buffer_load_dword v8, v6, s[44:47], s13 offen sc1
    s_add_u32 s66, s66, 1
    s_cmp_ge_u32 s66, 48
    s_cselect_b32 s67, 4194304, 0
    s_xor_b32 s13, s13, s67
    s_cmp_ge_u32 s66, 131072
    s_cbranch_scc1 L_end
    s_waitcnt vmcnt(0)
    v_cmp_ne_u32_sdwa vcc, v8, v13 src0_sel:BYTE_0 src1_sel:BYTE_0
    s_cbranch_vccnz L_poll_29
    s_mov_b64 exec, -1
    v_add_f32_dpp v9, v8, v8 quad_perm:[1,0,3,2] row_mask:0xf bank_mask:0xf
    v_mul_f32_dpp v12, v8, v12 row_newbcast:8 row_mask:0xf bank_mask:0xf
    s_nop 0
    v_add_f32_dpp v9, v9, v9 quad_perm:[2,3,0,1] row_mask:0xf bank_mask:0xf
    v_mul_f32 v8, v9, v12
    v_cvt_pk_bf16_f32 v8, v8, v8
    s_nop 1
    v_and_b32_dpp v68, v8, v124 row_newbcast:0 row_mask:0xf bank_mask:0xf
    v_and_b32_dpp v69, v8, v125 row_newbcast:0 row_mask:0xf bank_mask:0xf
    v_and_b32_dpp v70, v8, v124 row_newbcast:4 row_mask:0xf bank_mask:0xf
    v_and_b32_dpp v71, v8, v125 row_newbcast:4 row_mask:0xf bank_mask:0xf
    s_nop 1
    v_smfmac_f32_16x16x64_bf16 v[76:79], v[68:71], v[24:31], v126
    v_smfmac_f32_16x16x64_bf16 v[80:83], v[68:71], v[32:39], v126
    v_smfmac_f32_16x16x64_bf16 v[84:87], v[68:71], v[40:47], v126
    v_smfmac_f32_16x16x64_bf16 v[88:91], v[68:71], v[48:55], v126
    v_smfmac_f32_16x16x64_bf16 v[92:95], v[68:71], v[56:63], v126
    s_nop 1
    s_nop 1
    ds_write_b64 v7, v[76:77] offset:0
    ds_write_b64 v7, v[80:81] offset:640
    ds_write_b64 v7, v[84:85] offset:1280
    ds_write_b64 v7, v[88:89] offset:1920
    ds_write_b64 v7, v[92:93] offset:2560
    s_cmp_eq_u32 s3, 6
    s_cselect_b32 exec_hi, 0, -1
    s_cmp_eq_u32 s3, 7
    s_waitcnt lgkmcnt(0)
    s_barrier
    s_cbranch_scc1 L_end
    ds_read2_b64 v[24:27], v100 offset1:20
    ds_read2_b64 v[28:31], v101 offset1:20
    ds_read2_b64 v[32:35], v102 offset1:20
    ds_read2_b64 v[36:39], v103 offset1:20
    s_waitcnt lgkmcnt(2)
    v_pk_add_f32 v[16:17], v[24:25], v[28:29]
    v_pk_add_f32 v[18:19], v[26:27], v[30:31]
    s_waitcnt lgkmcnt(1)
    v_pk_add_f32 v[16:17], v[16:17], v[32:33]
    v_pk_add_f32 v[18:19], v[18:19], v[34:35]
    s_waitcnt lgkmcnt(0)
    v_pk_add_f32 v[16:17], v[16:17], v[36:37]
    v_pk_add_f32 v[18:19], v[18:19], v[38:39]
    buffer_store_dwordx4 v[16:19], v14, s[44:47], s8 offen sc1
    s_branch L_end
L_B_pv:
    s_waitcnt lgkmcnt(0)
    s_load_dword s42, s[44:45], 0
    s_load_dwordx8 s[32:39], s[0:1], 64
    s_mov_b32 s46, 16777216
    s_mov_b32 s47, 0x20000
    s_waitcnt lgkmcnt(0)
    s_add_u32 s43, s42, 0x9E3779B1
    s_branch L_B_pv3
L_B_pv2:
    buffer_store_dwordx4 v[36:39], v3, s[44:47], s14 offen sc1
    s_mov_b64 exec, -1
    s_waitcnt vmcnt(2)
    s_cmp_lg_u32 s3, 0
    s_cbranch_scc1 L_B_pv3
    s_lshl_b32 s7, s12, 7
    s_add_u32 s7, s7, 299008
    s_waitcnt vmcnt(0)
    v_dot2_f32_bf16 v24, v52, v60, 0
    v_dot2_f32_bf16 v24, v48, v56, v24
    v_dot2_f32_bf16 v24, v49, v57, v24
    v_dot2_f32_bf16 v24, v50, v58, v24
    v_dot2_f32_bf16 v24, v51, v59, v24
    s_nop 2
    v_add_f32_dpp v24, v24, v24 row_ror:8 row_mask:0xf bank_mask:0xf
    s_nop 1
    v_add_f32_dpp v24, v24, v24 row_ror:4 row_mask:0xf bank_mask:0xf
    s_nop 1
    v_add_f32_dpp v24, v24, v24 row_ror:2 row_mask:0xf bank_mask:0xf
    s_nop 1
    v_add_f32_dpp v24, v24, v24 row_ror:1 row_mask:0xf bank_mask:0xf
    v_mov_b32 v25, v24
    s_nop 1
    v_permlane16_swap_b32 v24, v25
    v_add_f32 v24, v24, v25
    v_mov_b32 v25, v24
    s_nop 1
    v_permlane32_swap_b32 v24, v25
    v_add_f32 v24, v24, v25
    v_mul_f32 v24, 3216550459, v24
    v_exp_f32 v24, v24
    s_nop 0
    v_add_f32 v24, 1.0, v24
    v_rcp_f32 v24, v24
    v_mov_b32 v25, 148480
    ds_write_b32 v25, v24
L_B_pv3:
    v_lshlrev_b32 v16, 7, v0
    s_lshl_b32 s78, s5, 12
    s_add_u32 s78, s78, 299008
    s_cmp_lg_u32 s3, 0
    s_cbranch_scc1 L_30
    s_mov_b32 exec_hi, 0
    buffer_load_dword v18, v16, s[44:47], s78 offen sc1
    s_mov_b32 exec_hi, -1
L_30:
    v_lshl_add_u32 v56, v2, 16, v5
    s_lshl_b32 s7, s5, 18
    s_lshl_b32 s8, s3, 13
    s_add_u32 s7, s7, s8
    s_lshl_b32 s8, s6, 8
    s_add_u32 s7, s7, s8
    s_add_u32 s72, s7, 2097152
    s_add_u32 s73, s7, 2129920
    v_lshrrev_b32 v6, 2, v0
    v_mul_u32_u24 v6, 1056, v6
    v_and_b32 v7, 3, v0
    v_lshl_add_u32 v6, v7, 3, v6
    s_lshl_b32 s7, s3, 8
    v_add_u32 v6, s7, v6
    v_add_u32 v7, 67584, v6
    v_add_u32 v4, 144384, v3
    s_lshl2_add_u32 s12, s6, s5
    s_lshl2_add_u32 s77, s12, s3
    s_mul_i32 s77, s77, 640
    s_add_u32 s77, s77, 610304
    v_lshrrev_b32 v57, 2, v0
    v_lshl_add_u32 v57, v57, 6, v3
    s_lshl_b32 s76, s5, 5
    s_add_u32 s76, s76, s6
    s_lshl_b32 s76, s76, 8
    s_add_u32 s76, s76, 315392
    v_lshlrev_b32 v58, 2, v1
    v_add_u32 v58, 143872, v58
    v_mov_b32 v59, 0xff800000
    ds_write_b32 v58, v59
    v_bfe_u32 v59, v0, 1, 1
    v_mul_u32_u24 v59, 0xaaaa, v59
    v_add_u32 v59, 0x4444, v59
    v_mov_b32 v64, 0
    v_mov_b32 v65, 0
    v_mov_b32 v66, 0
    v_mov_b32 v67, 0
    v_mov_b32 v68, 0
    v_mov_b32 v69, 0
    v_mov_b32 v70, 0
    v_mov_b32 v71, 0
    v_mov_b32 v72, 0
    v_mov_b32 v73, 0
    v_mov_b32 v74, 0
    v_mov_b32 v75, 0
    v_mov_b32 v76, 0
    v_mov_b32 v77, 0
    v_mov_b32 v78, 0
    v_mov_b32 v79, 0
    v_mov_b32 v80, 0
    v_mov_b32 v81, 0
    v_mov_b32 v82, 0
    v_mov_b32 v83, 0
    v_mov_b32 v84, 0
    v_mov_b32 v85, 0
    v_mov_b32 v86, 0
    v_mov_b32 v87, 0
    v_mov_b32 v88, 0
    v_mov_b32 v89, 0
    v_mov_b32 v90, 0
    v_mov_b32 v91, 0
    v_mov_b32 v92, 0
    v_mov_b32 v93, 0
    v_mov_b32 v94, 0
    v_mov_b32 v95, 0
    v_mov_b32 v63, s43
    v_mov_b32 v20, -1
    v_mov_b32 v21, -1
    v_mov_b32 v22, -1
    v_mov_b32 v23, -1
    s_lshl3_add_u32 s7, s5, s3
    s_lshl_b32 s13, s7, 10
    s_add_u32 s13, s13, 266240
    s_mul_i32 s7, s3, 1088
    s_add_u32 s7, s7, 135168
    v_add_u32 v17, s7, v3
    s_barrier
    buffer_store_dwordx4 v[20:23], v56, s[44:47], s72 offen sc1
    buffer_store_dwordx4 v[20:23], v56, s[44:47], s73 offen sc1
    s_mov_b32 exec_hi, 0xff
    buffer_store_dwordx4 v[20:23], v3, s[44:47], s77 offen sc1
    s_mov_b32 exec_hi, -1
    ds_read_b64_tr_b16 v[128:129], v6 offset:0
    ds_read_b64_tr_b16 v[132:133], v6 offset:33792
    ds_read_b64_tr_b16 v[136:137], v7 offset:0
    ds_read_b64_tr_b16 v[140:141], v7 offset:33792
    ds_read_b64_tr_b16 v[144:145], v6 offset:32
    ds_read_b64_tr_b16 v[148:149], v6 offset:33824
    ds_read_b64_tr_b16 v[152:153], v7 offset:32
    ds_read_b64_tr_b16 v[156:157], v7 offset:33824
    ds_read_b64_tr_b16 v[160:161], v6 offset:64
    ds_read_b64_tr_b16 v[164:165], v6 offset:33856
    ds_read_b64_tr_b16 v[168:169], v7 offset:64
    ds_read_b64_tr_b16 v[172:173], v7 offset:33856
    ds_read_b64_tr_b16 v[176:177], v6 offset:96
    ds_read_b64_tr_b16 v[180:181], v6 offset:33888
    ds_read_b64_tr_b16 v[184:185], v7 offset:96
    ds_read_b64_tr_b16 v[188:189], v7 offset:33888
    ds_read_b64_tr_b16 v[192:193], v6 offset:128
    ds_read_b64_tr_b16 v[196:197], v6 offset:33920
    ds_read_b64_tr_b16 v[200:201], v7 offset:128
    ds_read_b64_tr_b16 v[204:205], v7 offset:33920
    ds_read_b64_tr_b16 v[208:209], v6 offset:160
    ds_read_b64_tr_b16 v[212:213], v6 offset:33952
    ds_read_b64_tr_b16 v[216:217], v7 offset:160
    ds_read_b64_tr_b16 v[220:221], v7 offset:33952
    ds_read_b64_tr_b16 v[224:225], v6 offset:192
    ds_read_b64_tr_b16 v[228:229], v6 offset:33984
    ds_read_b64_tr_b16 v[232:233], v7 offset:192
    ds_read_b64_tr_b16 v[236:237], v7 offset:33984
    ds_read_b64_tr_b16 v[240:241], v6 offset:224
    ds_read_b64_tr_b16 v[244:245], v6 offset:34016
    ds_read_b64_tr_b16 v[248:249], v7 offset:224
    ds_read_b64_tr_b16 v[252:253], v7 offset:34016
    s_cmp_lg_u32 s3, 0
    s_cbranch_scc1 L_31
    s_mov_b32 exec_hi, 0
    s_mov_b32 s66, 0
    s_waitcnt vmcnt(3)
    s_branch L_chk_34
L_retry_32:
    buffer_load_dword v18, v16, s[44:47], s78 offen sc1
    s_add_u32 s66, s66, 1
    s_cmp_ge_u32 s66, 131072
    s_cbranch_scc1 L_end
L_wait_33:
    s_waitcnt vmcnt(0)
L_chk_34:
    v_cmp_ne_u32 vcc, s43, v18
    s_cbranch_vccnz L_retry_32
    s_mov_b32 exec_hi, -1
L_31:
    s_barrier
    buffer_load_dwordx4 v[8:11], v3, s[44:47], s13 offen sc1
    ds_read_b64_tr_b16 v[130:131], v6 offset:16896
    ds_read_b64_tr_b16 v[134:135], v6 offset:50688
    ds_read_b64_tr_b16 v[138:139], v7 offset:16896
    ds_read_b64_tr_b16 v[142:143], v7 offset:50688
    ds_read_b64_tr_b16 v[146:147], v6 offset:16928
    ds_read_b64_tr_b16 v[150:151], v6 offset:50720
    ds_read_b64_tr_b16 v[154:155], v7 offset:16928
    ds_read_b64_tr_b16 v[158:159], v7 offset:50720
    ds_read_b64_tr_b16 v[162:163], v6 offset:16960
    ds_read_b64_tr_b16 v[166:167], v6 offset:50752
    ds_read_b64_tr_b16 v[170:171], v7 offset:16960
    ds_read_b64_tr_b16 v[174:175], v7 offset:50752
    ds_read_b64_tr_b16 v[178:179], v6 offset:16992
    ds_read_b64_tr_b16 v[182:183], v6 offset:50784
    ds_read_b64_tr_b16 v[186:187], v7 offset:16992
    ds_read_b64_tr_b16 v[190:191], v7 offset:50784
    ds_read_b64_tr_b16 v[194:195], v6 offset:17024
    ds_read_b64_tr_b16 v[198:199], v6 offset:50816
    ds_read_b64_tr_b16 v[202:203], v7 offset:17024
    ds_read_b64_tr_b16 v[206:207], v7 offset:50816
    ds_read_b64_tr_b16 v[210:211], v6 offset:17056
    ds_read_b64_tr_b16 v[214:215], v6 offset:50848
    ds_read_b64_tr_b16 v[218:219], v7 offset:17056
    ds_read_b64_tr_b16 v[222:223], v7 offset:50848
    s_mov_b32 s66, 0
    s_branch L_wait_36
L_retry_35:
    buffer_load_dwordx4 v[8:11], v3, s[44:47], s13 offen sc1
    s_add_u32 s66, s66, 1
    s_cmp_ge_u32 s66, 131072
    s_cbranch_scc1 L_end
L_wait_36:
    s_waitcnt vmcnt(0)
L_chk_37:
    ds_write_b128 v17, v[8:11]
    v_cmp_eq_u32 vcc, -1, v11
    s_cbranch_vccnz L_retry_35
    s_waitcnt lgkmcnt(0)
    s_barrier
    ds_read_b64_tr_b16 v[226:227], v6 offset:17088
    ds_read_b64_tr_b16 v[230:231], v6 offset:50880
    ds_read_b64_tr_b16 v[234:235], v7 offset:17088
    ds_read_b64_tr_b16 v[238:239], v7 offset:50880
    ds_read_b64_tr_b16 v[242:243], v6 offset:17120
    ds_read_b64_tr_b16 v[246:247], v6 offset:50912
    ds_read_b64_tr_b16 v[250:251], v7 offset:17120
    ds_read_b64_tr_b16 v[254:255], v7 offset:50912
    s_barrier
    s_cmp_lg_u32 s3, 3
    s_cbranch_scc1 L_38
    ds_read_b32 v60, v58
    s_waitcnt lgkmcnt(0)
    s_mov_b64 exec, 0xff
    buffer_store_dwordx4 v[60:63], v57, s[44:47], s76 offen sc1
    s_mov_b64 exec, -1
L_38:
    s_waitcnt lgkmcnt(0)
    s_barrier
    ds_read_b128 v[100:103], v4 offset:0
    ds_read_b128 v[104:107], v4 offset:1024
    s_waitcnt lgkmcnt(1)
    v_smfmac_f32_16x16x64_bf16 v[64:67], v[100:103], v[128:135], v59
    v_smfmac_f32_16x16x64_bf16 v[68:71], v[100:103], v[144:151], v59
    s_waitcnt lgkmcnt(0)
    v_smfmac_f32_16x16x64_bf16 v[64:67], v[104:107], v[136:143], v59
    v_smfmac_f32_16x16x64_bf16 v[68:71], v[104:107], v[152:159], v59
    v_smfmac_f32_16x16x64_bf16 v[72:75], v[100:103], v[160:167], v59
    v_smfmac_f32_16x16x64_bf16 v[76:79], v[100:103], v[176:183], v59
    v_smfmac_f32_16x16x64_bf16 v[72:75], v[104:107], v[168:175], v59
    v_smfmac_f32_16x16x64_bf16 v[76:79], v[104:107], v[184:191], v59
    v_smfmac_f32_16x16x64_bf16 v[80:83], v[100:103], v[192:199], v59
    v_smfmac_f32_16x16x64_bf16 v[84:87], v[100:103], v[208:215], v59
    v_smfmac_f32_16x16x64_bf16 v[80:83], v[104:107], v[200:207], v59
    v_smfmac_f32_16x16x64_bf16 v[84:87], v[104:107], v[216:223], v59
    v_smfmac_f32_16x16x64_bf16 v[88:91], v[100:103], v[224:231], v59
    v_pk_add_f32 v[64:65], v[64:65], v[66:67]
    v_smfmac_f32_16x16x64_bf16 v[92:95], v[100:103], v[240:247], v59
    v_pk_add_f32 v[68:69], v[68:69], v[70:71]
    v_smfmac_f32_16x16x64_bf16 v[88:91], v[104:107], v[232:239], v59
    v_cvt_pk_bf16_f32 v20, v64, v68
    v_smfmac_f32_16x16x64_bf16 v[92:95], v[104:107], v[248:255], v59
    v_cvt_pk_bf16_f32 v24, v65, v69
    v_pk_add_f32 v[72:73], v[72:73], v[74:75]
    v_pk_add_f32 v[76:77], v[76:77], v[78:79]
    v_cvt_pk_bf16_f32 v21, v72, v76
    v_cvt_pk_bf16_f32 v25, v73, v77
    v_pk_add_f32 v[80:81], v[80:81], v[82:83]
    v_pk_add_f32 v[84:85], v[84:85], v[86:87]
    v_cvt_pk_bf16_f32 v22, v80, v84
    v_cvt_pk_bf16_f32 v26, v81, v85
    v_pk_add_f32 v[88:89], v[88:89], v[90:91]
    v_pk_add_f32 v[92:93], v[92:93], v[94:95]
    v_cvt_pk_bf16_f32 v23, v88, v92
    buffer_store_dwordx4 v[20:23], v56, s[44:47], s72 offen sc1
    v_cvt_pk_bf16_f32 v27, v89, v93
    buffer_store_dwordx4 v[24:27], v56, s[44:47], s73 offen sc1
    s_barrier
L_end:
L_exit:
    s_endpgm
L_code_end:
.fill (16640 - (L_code_end - gated_mix__compressed_kv_cla__dense_activation_silu__decode_kernel)) / 4, 4, 0xbf810000
.section .rodata,"a"
.p2align 6
.amdhsa_kernel gated_mix__compressed_kv_cla__dense_activation_silu__decode_kernel
  .amdhsa_next_free_vgpr 256
  .amdhsa_next_free_sgpr 102
  .amdhsa_accum_offset 256
  .amdhsa_group_segment_fixed_size 0
  .amdhsa_kernarg_size 104
  .amdhsa_user_sgpr_count 2
  .amdhsa_user_sgpr_kernarg_segment_ptr 1
  .amdhsa_system_sgpr_workgroup_id_x 1
  .amdhsa_float_denorm_mode_32 3
.end_amdhsa_kernel
```
